```python
import torch

def _softmax(x, axis=-1):
    return torch.softmax(x, dim=axis)
def _gelu(x):
    return torch.nn.functional.gelu(x, approximate="tanh")
def _silu(x):
    return torch.nn.functional.silu(x)
def _sigmoid(x):
    return torch.sigmoid(x)
def _layernorm(x, axis=-1, eps=1e-5):
    m = x.mean(dim=axis, keepdim=True)
    v = x.var(dim=axis, keepdim=True, unbiased=False)
    return (x - m) / torch.sqrt(v + eps)
def _scatter_add(tgt, idx, src, axis=0):
    return tgt.clone().index_add_(axis, idx, src)
def _segment_sum(src, seg, n):
    out = torch.zeros((n,) + src.shape[1:], dtype=src.dtype)
    return out.index_add_(0, seg, src)
def _pad(x, pw):
    flat = tuple(v for pair in reversed(pw) for v in pair)
    return torch.nn.functional.pad(x, flat)

kernel_name = 'standalone__spectral_fnet__prompt'

def setup_inputs():

    _w = (lambda a: (lambda t: t.to(torch.bfloat16) if t.is_floating_point() else t)(torch.as_tensor(a)))
    B, S, D = 1, 2048, 640
    ns = torch.arange(S)[:, None] * torch.arange(S)[None, :]
    nd = torch.arange(D)[:, None] * torch.arange(D)[None, :]
    Ws_re = torch.cos(-2.0 * torch.pi * ns / S).to(float)
    Ws_im = torch.sin(-2.0 * torch.pi * ns / S).to(float)
    Wd_re = torch.cos(-2.0 * torch.pi * nd / D).to(float)
    Wd_im = torch.sin(-2.0 * torch.pi * nd / D).to(float)
    return {
        "x": _w((lambda *s: torch.randn(*s, dtype=torch.bfloat16) * 0.05)(B, S, D)),
        "dft_seq_re": _w(Ws_re),
        "dft_seq_im": _w(Ws_im),
        "dft_hid_re": _w(Wd_re),
        "dft_hid_im": _w(Wd_im),
    }

def reference(x, dft_seq_re, dft_seq_im, dft_hid_re, dft_hid_im):
    a = torch.einsum("bsd,ed->bse", x, dft_hid_re)
    b = torch.einsum("bsd,ed->bse", x, dft_hid_im)
    y = torch.einsum("ts,bse->bte", dft_seq_re, a) - torch.einsum("ts,bse->bte", dft_seq_im, b)
    return y
```

```asm
; @launch grid=(256,1,1) block=(512,1,1) lds=29696
.amdgcn_target "amdgcn-amd-amdhsa--gfx950"
.text
.globl standalone__spectral_fnet__prompt_kernel
.p2align 8
.type standalone__spectral_fnet__prompt_kernel,@function
standalone__spectral_fnet__prompt_kernel:
    s_load_dwordx2 s[4:5], s[0:1], 0
    s_load_dwordx2 s[16:17], s[0:1], 56
    s_getpc_b64 s[24:25]
L_pf:
    v_lshlrev_b32 v126, 3, v0
    v_min_u32 v126, L_codeend-L_pf-4, v126
    v_mov_b32 v127, 0
    v_lshl_add_u64 v[126:127], v[126:127], 0, s[24:25]
    global_load_dword v122, v[126:127], off
    v_lshrrev_b32 v3, 6, v0
    s_lshr_b32 s13, s2, 4
    v_bfe_u32 v2, v0, 4, 2
    s_and_b32 s23, s13, 1
    v_readfirstlane_b32 s20, v3
    s_min_u32 s14, s13, 14
    v_lshl_add_u32 v21, v3, 1, s23
    s_mulk_i32 s14, 683
    v_and_b32 v22, 15, v0
    s_lshr_b32 s14, s14, 6
    v_bfe_u32 v7, v0, 2, 2
    s_cmp_ge_u32 s13, 16
    s_cbranch_scc1 L_end
    s_cmp_ge_u32 s20, 4
    s_cbranch_scc1 L_aux
    s_and_b32 s15, s14, 31
    v_lshl_add_u32 v21, v2, 5, v21
    s_sub_u32 s14, s14, s15
    v_sub_u32 v6, v22, v7
    s_and_b32 s12, s2, 15
    v_mul_u32_u24 v4, 20480, v21
    s_mul_i32 s28, s12, 1280
    v_add3_u32 v6, v6, s15, -1
    s_lshl2_add_u32 s28, s14, s28
    v_med3_i32 v16, v6, 0, 31
    s_mov_b32 s14, 163840
    v_cmp_le_i32 vcc, 0, v6
    s_add_u32 s29, s28, s14
    v_lshl_add_u32 v16, v16, 2, v4
    s_add_u32 s30, s29, s14
    v_mov_b64 v[12:13], 0
    s_add_u32 s31, s30, s14
    v_mov_b64 v[14:15], 0
    s_sub_u32 s22, 2131196, s28
    v_mov_b64 v[68:69], 0
    s_lshl_b32 s6, s14, 4
    v_sub_u32 v17, s22, v16
    s_mov_b32 s7, 0x20000
    v_add_u32 v18, 491520, v17
    s_lshl_b32 s15, s14, 1
    v_subrev_u32 v19, s6, v18
    s_lshl_b32 s21, s7, 4
    v_mov_b64 v[70:71], 0
    s_mul_i32 s26, s23, -40960
    v_min_u32 v23, v18, v19
    s_add_u32 s26, s26, 20480
    v_add_u32 v88, s26, v16
    s_mov_b32 s18, 2097280
    v_subrev_u32 v89, s26, v17
    s_mov_b32 s19, s7
    v_subrev_u32 v18, s26, v18
    s_brev_b32 s43, 1
    v_subrev_u32 v19, s26, v19
    v_min_u32 v90, v18, v19
    s_waitcnt lgkmcnt(0)
    s_load_dword s36, s[16:17], s21
    buffer_load_dword v8, v16, s[4:7], s28 offen nt
    buffer_load_dword v9, v16, s[4:7], s29 offen nt
    buffer_load_dword v10, v16, s[4:7], s30 offen nt
    buffer_load_dword v11, v16, s[4:7], s31 offen nt
    s_mov_b64 exec, vcc
    buffer_load_dword v12, v23, s[4:7], 0 offen nt
    buffer_load_dword v13, v17, s[4:7], s15 offen nt
    buffer_load_dword v14, v17, s[4:7], s14 offen nt
    buffer_load_dword v15, v17, s[4:7], 0 offen nt
    s_mov_b64 exec, -1
    buffer_load_dword v64, v88, s[4:7], s28 offen nt
    buffer_load_dword v65, v88, s[4:7], s29 offen nt
    buffer_load_dword v66, v88, s[4:7], s30 offen nt
    buffer_load_dword v67, v88, s[4:7], s31 offen nt
    s_mov_b64 exec, vcc
    buffer_load_dword v68, v90, s[4:7], 0 offen nt
    buffer_load_dword v69, v89, s[4:7], s15 offen nt
    buffer_load_dword v70, v89, s[4:7], s14 offen nt
    buffer_load_dword v71, v89, s[4:7], 0 offen nt
    s_mov_b64 exec, -1
    s_load_dwordx2 s[8:9], s[0:1], 40
    v_and_b32 v1, 3, v0
    v_and_b32 v20, 1, v0
    v_bfe_u32 v23, v0, 1, 3
    v_lshl_add_u32 v20, v20, 3, v23
    v_xor_b32 v18, 1, v21
    v_cvt_f32_u32 v20, v20
    v_cvt_f32_u32 v21, v21
    v_cvt_f32_u32 v18, v18
    v_mul_f32 v20, 0x3c000000, v20
    v_mul_f32 v21, v21, v20
    v_mul_f32 v18, v18, v20
    v_mul_f32 v20, 0x41000000, v20
    s_mov_b32 s33, 0
    v_cos_f32 v112, v21
    v_sin_f32 v113, v21
    v_add_f32 v21, v21, v20
    v_cos_f32 v114, v21
    v_sin_f32 v115, v21
    v_add_f32 v21, v21, v20
    v_cos_f32 v116, v21
    v_sin_f32 v117, v21
    v_add_f32 v21, v21, v20
    v_cos_f32 v118, v21
    v_sin_f32 v119, v21
    v_ashrrev_i32 v125, 31, v6
    v_cmp_eq_u32 vcc, 31, v6
    v_and_b32 v124, 3854, v125
    v_mov_b32 v126, 0x0c0c0302
    v_xor_b32 v124, 0x05040302, v124
    v_cndmask_b32 v124, v124, v126, vcc
    v_cvt_pk_bf16_f32 v96, v112, v113
    s_lshr_b32 s34, s2, 5
    v_cvt_pk_bf16_f32 v100, -v113, v112
    s_lshl_b32 s34, s34, 3
    v_cvt_pk_bf16_f32 v104, v113, v112
    s_and_b32 s35, s2, 7
    v_cvt_pk_bf16_f32 v108, v112, -v113
    v_cvt_pk_bf16_f32 v97, v114, v115
    s_or_b32 s34, s34, s35
    v_cvt_pk_bf16_f32 v101, -v115, v114
    s_bfe_u32 s42, s2, 0x20003
    v_cvt_pk_bf16_f32 v105, v115, v114
    s_lshl_b32 s42, s42, 9
    v_cvt_pk_bf16_f32 v109, v114, -v115
    v_cvt_pk_bf16_f32 v98, v116, v117
    s_and_b32 s35, s2, 0xf7
    v_cvt_pk_bf16_f32 v102, -v117, v116
    s_cmp_eq_u32 s35, 16
    v_cvt_pk_bf16_f32 v106, v117, v116
    s_cselect_b32 s34, 64, s34
    v_cvt_pk_bf16_f32 v110, v116, -v117
    v_cvt_pk_bf16_f32 v99, v118, v119
    s_cselect_b32 s35, 1024, 0
    v_cvt_pk_bf16_f32 v103, -v119, v118
    s_sub_u32 s42, s42, s35
    v_cvt_pk_bf16_f32 v107, v119, v118
    s_add_u32 s42, s42, s34
    v_cvt_pk_bf16_f32 v111, v118, -v119
    v_cos_f32 v88, v18
    v_sin_f32 v89, v18
    v_add_f32 v18, v18, v20
    v_cos_f32 v90, v18
    v_sin_f32 v91, v18
    v_add_f32 v18, v18, v20
    v_cos_f32 v92, v18
    v_sin_f32 v93, v18
    v_add_f32 v18, v18, v20
    v_cos_f32 v94, v18
    v_sin_f32 v95, v18
    v_and_b32 v4, 1, v7
    v_lshlrev_b32 v4, 1, v4
    v_xor_b32 v4, v4, v2
    v_lshl_add_u32 v4, v1, 2, v4
    v_lshl_add_u32 v4, v7, 8, v4
    s_lshl_b32 s21, s20, 7
    s_lshl2_add_u32 s21, s23, s21
    v_lshl_add_u32 v4, v4, 3, s21
    v_xor_b32 v127, 4, v4
    v_cvt_pk_bf16_f32 v72, v88, v89
    v_cvt_pk_bf16_f32 v76, -v89, v88
    v_cvt_pk_bf16_f32 v80, v89, v88
    v_cvt_pk_bf16_f32 v84, v88, -v89
    v_cvt_pk_bf16_f32 v73, v90, v91
    v_cvt_pk_bf16_f32 v77, -v91, v90
    v_cvt_pk_bf16_f32 v81, v91, v90
    v_cvt_pk_bf16_f32 v85, v90, -v91
    v_cvt_pk_bf16_f32 v74, v92, v93
    v_cvt_pk_bf16_f32 v78, -v93, v92
    v_cvt_pk_bf16_f32 v82, v93, v92
    v_cvt_pk_bf16_f32 v86, v92, -v93
    v_cvt_pk_bf16_f32 v75, v94, v95
    v_cvt_pk_bf16_f32 v79, -v95, v94
    v_cvt_pk_bf16_f32 v83, v95, v94
    v_cvt_pk_bf16_f32 v87, v94, -v95
    v_cvt_f32_u32 v20, v23
    v_and_b32 v21, 1, v0
    v_cvt_f32_u32 v21, v21
    v_cvt_f32_u32 v33, v2
    v_mul_f32 v20, 0x3e000000, v20
    v_mul_f32 v21, 0x3e800000, v21
    v_add_f32 v33, v33, v33
    v_fma_f32 v21, v33, v20, v21
    v_add_f32 v20, v20, v21
    v_cos_f32 v120, v21
    v_sin_f32 v121, v21
    v_cos_f32 v18, v20
    v_sin_f32 v19, v20
    v_and_b32 v125, 63, v0
    s_and_b32 s22, s20, 1
    s_lshl_b32 s22, s22, 1
    v_xor_b32 v5, s22, v125
    s_lshl_b32 s21, s20, 11
    v_lshl_add_u32 v5, v5, 3, s21
    v_lshl_add_u32 v6, v2, 3, v3
    v_lshl_add_u32 v6, v6, 2, v7
    v_lshlrev_b32 v6, 14, v6
    v_lshl_add_u32 v6, v1, 4, v6
    v_cvt_pk_bf16_f32 v16, v120, v121
    v_cvt_pk_bf16_f32 v17, v18, v19
    s_lshl_b32 s28, s12, 10
    s_lshl_b32 s29, s13, 6
    s_add_u32 s28, s28, s29
    s_add_u32 s29, s28, 262144
    s_waitcnt vmcnt(12)
    v_mov_b32_dpp v120, v8 quad_perm:[1,2,3,3] row_mask:0xf bank_mask:0xf
    v_mov_b32_dpp v121, v9 quad_perm:[1,2,3,3] row_mask:0xf bank_mask:0xf
    v_mov_b32_dpp v122, v10 quad_perm:[1,2,3,3] row_mask:0xf bank_mask:0xf
    v_mov_b32_dpp v123, v11 quad_perm:[1,2,3,3] row_mask:0xf bank_mask:0xf
    v_perm_b32 v8, v120, v8, v124
    v_perm_b32 v9, v121, v9, v124
    v_perm_b32 v10, v122, v10, v124
    v_perm_b32 v11, v123, v11, v124
    s_nop 1
    v_mfma_f32_16x16x32_bf16 v[112:115], v[8:11], v[96:99], 0
    v_mfma_f32_16x16x32_bf16 v[116:119], v[8:11], v[100:103], 0
    s_waitcnt vmcnt(8)
    v_mfma_f32_16x16x32_bf16 v[112:115], v[12:15], v[104:107], v[112:115]
    v_mfma_f32_16x16x32_bf16 v[116:119], v[12:15], v[108:111], v[116:119]
    s_waitcnt vmcnt(4)
    v_mov_b32_dpp v120, v64 quad_perm:[1,2,3,3] row_mask:0xf bank_mask:0xf
    v_mov_b32_dpp v121, v65 quad_perm:[1,2,3,3] row_mask:0xf bank_mask:0xf
    v_mov_b32_dpp v122, v66 quad_perm:[1,2,3,3] row_mask:0xf bank_mask:0xf
    v_mov_b32_dpp v123, v67 quad_perm:[1,2,3,3] row_mask:0xf bank_mask:0xf
    v_perm_b32 v64, v120, v64, v124
    v_perm_b32 v65, v121, v65, v124
    v_perm_b32 v66, v122, v66, v124
    v_perm_b32 v67, v123, v67, v124
    s_nop 1
    v_mfma_f32_16x16x32_bf16 v[88:91], v[64:67], v[72:75], 0
    v_mfma_f32_16x16x32_bf16 v[92:95], v[64:67], v[76:79], 0
    v_cvt_pk_bf16_f32 v8, v112, v116
    ds_write_b32 v4, v8 offset:0
    v_cvt_pk_bf16_f32 v9, v113, v117
    ds_write_b32 v4, v9 offset:512
    v_cvt_pk_bf16_f32 v10, v114, v118
    ds_write_b32 v4, v10 offset:1024
    s_waitcnt vmcnt(0)
    v_mfma_f32_16x16x32_bf16 v[88:91], v[68:71], v[80:83], v[88:91]
    v_mfma_f32_16x16x32_bf16 v[92:95], v[68:71], v[84:87], v[92:95]
    s_nop 7
    v_cvt_pk_bf16_f32 v64, v88, v92
    ds_write_b32 v127, v64 offset:0
    v_cvt_pk_bf16_f32 v65, v89, v93
    ds_write_b32 v127, v65 offset:512
    v_cvt_pk_bf16_f32 v66, v90, v94
    ds_write_b32 v127, v66 offset:1024
    s_waitcnt lgkmcnt(0)
    s_barrier
    ds_read_b64 v[8:9], v5 offset:0
    ds_read_b64 v[10:11], v5 offset:512
    ds_read_b64 v[12:13], v5 offset:1024
    s_add_u32 s36, s36, 2654435769
    v_mov_b32 v27, s36
    v_mov_b32 v31, s36
    s_waitcnt lgkmcnt(2)
    v_mfma_f32_16x16x16_bf16 v[96:99], v[16:17], v[8:9], 0
    s_waitcnt lgkmcnt(1)
    v_mfma_f32_16x16x16_bf16 v[100:103], v[16:17], v[10:11], 0
    s_waitcnt lgkmcnt(0)
    v_mfma_f32_16x16x16_bf16 v[104:107], v[16:17], v[12:13], 0
    s_nop 3
    v_cvt_pk_bf16_f32 v24, v96, v97
    v_cvt_pk_bf16_f32 v28, v98, v99
    v_cvt_pk_bf16_f32 v25, v100, v101
    v_cvt_pk_bf16_f32 v29, v102, v103
    v_cvt_pk_bf16_f32 v26, v104, v105
    buffer_store_dwordx4 v[24:27], v6, s[16:19], s28 offen sc1
    v_cvt_pk_bf16_f32 v30, v106, v107
    buffer_store_dwordx4 v[28:31], v6, s[16:19], s29 offen sc1
    s_sub_u32 s35, 128, s34
    s_and_b32 s38, s34, 0x70
    s_and_b32 s21, s34, 7
    s_lshl1_add_u32 s38, s21, s38
    s_bfe_u32 s21, s34, 0x10003
    s_add_u32 s38, s38, s21
    s_lshl_b32 s38, s38, 14
    s_add_u32 s39, s38, 8192
    s_and_b32 s40, s35, 0x70
    s_and_b32 s21, s35, 7
    s_lshl1_add_u32 s40, s21, s40
    s_bfe_u32 s21, s35, 0x10003
    s_add_u32 s40, s40, s21
    s_lshl_b32 s40, s40, 14
    s_add_u32 s41, s40, 8192
    v_lshlrev_b32 v5, 11, v2
    v_lshl_add_u32 v5, v3, 8, v5
    v_lshl_add_u32 v5, v22, 4, v5
    v_lshl_add_u32 v68, v3, 2, v7
    v_min_u32 v68, 14, v68
    v_mul_u32_u24 v69, 43, v68
    v_lshrrev_b32 v69, 7, v69
    v_mad_i32_i24 v68, v69, -3, v68
    v_mul_u32_u24 v68, 21, v68
    v_lshrrev_b32 v68, 1, v68
    v_mad_u32_u24 v68, v1, 3, v68
    v_lshl_add_u32 v70, v69, 5, v68
    v_cmp_eq_u32 vcc, 0, v68
    v_cmp_ne_u32 s[46:47], 0, v69
    v_add_u32 v69, 162, v69
    v_mul_u32_u24 v6, 1408, v2
    s_and_b64 vcc, vcc, s[46:47]
    v_cndmask_b32 v69, v70, v69, vcc
    v_lshl_add_u32 v4, v69, 3, v6
    v_lshl_add_u32 v6, v70, 3, v6
    v_and_b32 v69, 1, v0
    s_cmp_eq_u32 s2, 0
    s_cselect_b32 s31, 1, 99
    v_and_b32 v70, 13, v0
    v_cmp_eq_u32 vcc, s31, v70
    v_lshlrev_b32 v71, 1, v2
    v_cvt_f32_u32 v71, v71
    v_bfe_u32 v70, v0, 1, 1
    v_cndmask_b32 v68, v7, 8, vcc
    v_cndmask_b32 v69, v69, 0, vcc
    v_lshl_add_u32 v68, v68, 7, s42
    v_cvt_f32_u32 v68, v68
    v_mul_f32 v68, 0x3a000000, v68
    v_add_u32 v69, v69, v70
    v_cvt_f32_u32 v69, v69
    v_mul_f32 v69, 0x3e800000, v69
    v_fma_f32 v69, v68, v71, v69
    v_add_f32 v71, v69, v68
    v_cos_f32 v72, v69
    v_sin_f32 v73, v69
    v_cos_f32 v74, v71
    v_sin_f32 v75, v71
    v_fmamk_f32 v69, v68, 0x41000000, v69
    v_fmamk_f32 v71, v68, 0x41000000, v71
    v_cos_f32 v76, v69
    v_sin_f32 v77, v69
    v_cos_f32 v78, v71
    v_sin_f32 v79, v71
    v_lshlrev_b32 v70, 4, v70
    v_lshrrev_b32 v70, v70, s43
    v_pk_mul_f32 v[72:73], v[72:73], 0.5 op_sel_hi:[1,0]
    v_pk_mul_f32 v[74:75], v[74:75], 0.5 op_sel_hi:[1,0]
    v_pk_mul_f32 v[76:77], v[76:77], 0.5 op_sel_hi:[1,0]
    v_pk_mul_f32 v[78:79], v[78:79], 0.5 op_sel_hi:[1,0]
    v_cvt_pk_bf16_f32 v24, v72, v73
    v_cvt_pk_bf16_f32 v26, v74, v75
    v_cvt_pk_bf16_f32 v28, v76, v77
    v_cvt_pk_bf16_f32 v30, v78, v79
    v_xor_b32 v25, v24, v70
    v_xor_b32 v27, v26, v70
    v_xor_b32 v29, v28, v70
    v_xor_b32 v31, v30, v70
L_rdc:
    v_and_b32 v96, 63, v0
    v_lshlrev_b32 v97, 4, v96
    ds_read_b128 v[32:35], v97 offset:14336
    ds_read_b128 v[36:39], v97 offset:15360
    ds_read_b64 v[40:41], v97 offset:16384
    ds_read_b128 v[44:47], v97 offset:17408
    ds_read_b128 v[48:51], v97 offset:18432
    ds_read_b64 v[52:53], v97 offset:19456
    ds_read_b128 v[56:59], v97 offset:20480
    ds_read_b128 v[60:63], v97 offset:21504
    ds_read_b64 v[64:65], v97 offset:22528
    ds_read_b128 v[68:71], v97 offset:23552
    ds_read_b128 v[72:75], v97 offset:24576
    ds_read_b64 v[76:77], v97 offset:25600
    ds_read_b128 v[80:83], v97 offset:26624
    ds_read_b128 v[84:87], v97 offset:27648
    ds_read_b64 v[88:89], v97 offset:28672
    v_add_u32 v54, 16, v96
    v_and_b32 v96, 15, v0
    v_cvt_f32_u32 v97, v96
    v_cvt_f32_u32 v98, v2
    v_mul_f32 v97, 0x3d800000, v97
    v_add_f32 v98, v98, v98
    v_mul_f32 v98, v98, v97
    v_add_f32 v97, v97, v98
    v_cos_f32 v99, v98
    v_sin_f32 v100, v98
    v_cos_f32 v101, v97
    v_sin_f32 v102, v97
    s_and_b32 s25, s20, 3
    s_mul_i32 s24, s25, 1408
    s_add_u32 s24, s24, 8196
    v_min_u32 v1, 1, v1
    v_lshl_add_u32 v7, v7, 1, v1
    v_mul_u32_u24 v3, 320, v2
    v_add_u32 v3, s24, v3
    v_lshl_add_u32 v7, v7, 2, v3
    v_lshl_add_u32 v3, v96, 2, v3
    v_lshl_add_u32 v55, v2, 3, s24
    v_mov_b32 v66, s24
    v_lshlrev_b32 v1, 3, v2
    v_lshl_add_u32 v1, v96, 5, v1
    v_lshlrev_b32 v2, 28, v96
    v_and_or_b32 v2, v2, s43, v1
    v_cvt_pk_bf16_f32 v92, v99, v100
    v_cvt_pk_bf16_f32 v93, v101, v102
    v_cvt_pk_bf16_f32 v108, -v100, v99
    v_cvt_pk_bf16_f32 v109, -v102, v101
    s_lshl_b32 s21, s25, 7
    s_add_u32 s21, s21, s42
    s_sub_u32 s22, 2048, s21
    s_mul_i32 s22, s22, 1280
    s_lshr_b32 s27, s21, 6
    s_and_b32 s23, s21, 1023
    s_cselect_b32 s22, s22, 0
    s_cselect_b32 s23, 0, s43
    s_cselect_b32 s26, -1, 0xffff
    s_cselect_b32 s27, 0, s27
    s_mul_i32 s21, s21, 1280
    s_mul_i32 s25, s27, 0x202000
    s_add_u32 s25, s25, 0x01000c0c
    s_mov_b32 s50, 0
    s_mov_b32 s51, s43
    v_sub_u32 v43, 248, v1
    v_and_b32 v43, 0x80000fff, v43
    v_and_b32 v42, 8, v1
    v_mad_u32_u24 v1, v42, 63, v1
    v_sub_u32 v42, 1264, v1
    v_or_b32 v42, s23, v42
    v_or_b32 v43, s23, v43
    v_lshrrev_b32 v96, 6, v54
    v_and_b32 v54, 63, v54
    v_add_lshl_u32 v54, v54, v96, 2
    v_cndmask_b32 v54, v54, 0, s[50:51]
    s_mov_b32 s10, 2621440
    s_mov_b32 s11, 0x20000
    s_mov_b64 s[44:45], 0x1000000
    s_movk_i32 s52, 0x100
    s_mov_b32 s53, 0x10000
    s_mov_b32 s54, 0
    s_mov_b32 s55, 1
    s_mov_b32 s56, 0x00ff00ff
    s_mov_b32 s57, s56
    s_mov_b32 vcc_lo, -1
    s_mov_b32 vcc_hi, 0
    v_and_b32 v92, s26, v92
    v_and_b32 v93, s26, v93
    v_and_b32 v108, s26, v108
    v_and_b32 v109, s26, v109
    v_lshlrev_b32 v92, s27, v92
    v_lshlrev_b32 v93, s27, v93
    v_lshlrev_b32 v108, s27, v108
    v_lshlrev_b32 v109, s27, v109
    v_mov_b32 v95, 0
    v_mov_b32 v111, 0
    v_cndmask_b32 v94, v92, v93, vcc
    v_cndmask_b32 v110, v108, v109, vcc
    s_mov_b64 s[48:49], -1
    s_cmp_eq_u32 s20, 4
    s_cbranch_scc1 L_b3
L_retry:
    s_wqm_b64 s[46:47], s[48:49]
    s_mov_b64 exec, s[46:47]
    s_add_u32 s33, s33, 1
    s_cmp_ge_u32 s33, 2000000
    s_cbranch_scc1 L_go
    s_waitcnt vmcnt(0)
    buffer_load_dwordx4 v[8:11], v5, s[16:19], s38 offen offset:0 sc1
    buffer_load_dwordx4 v[12:15], v5, s[16:19], s40 offen offset:0 sc1
    buffer_load_dwordx4 v[16:19], v5, s[16:19], s38 offen offset:1024 sc1
    buffer_load_dwordx4 v[20:23], v5, s[16:19], s40 offen offset:1024 sc1
    buffer_load_dwordx4 v[112:115], v5, s[16:19], s39 offen offset:0 sc1
    buffer_load_dwordx4 v[116:119], v5, s[16:19], s41 offen offset:0 sc1
    buffer_load_dwordx4 v[120:123], v5, s[16:19], s39 offen offset:1024 sc1
    buffer_load_dwordx4 v[124:127], v5, s[16:19], s41 offen offset:1024 sc1
L_wait:
    s_waitcnt vmcnt(7)
    v_cmpx_eq_u32 vcc, s36, v11
    s_waitcnt vmcnt(6)
    v_cmpx_eq_u32 vcc, s36, v15
    v_swap_b32 v9, v12
    s_waitcnt vmcnt(5)
    v_cmpx_eq_u32 vcc, s36, v19
    v_swap_b32 v10, v16
    v_swap_b32 v14, v17
    s_waitcnt vmcnt(4)
    v_cmpx_eq_u32 vcc, s36, v23
    v_mov_b32 v11, v20
    v_mov_b32 v15, v21
    v_mov_b32 v19, v22
    s_mov_b64 exec, -1
    v_mfma_f32_16x16x32_bf16 v[96:99], v[24:27], v[8:11], 0
    v_mfma_f32_16x16x32_bf16 v[100:103], v[24:27], v[12:15], 0
    v_mfma_f32_16x16x32_bf16 v[104:107], v[24:27], v[16:19], 0
    s_mov_b64 exec, vcc
    s_waitcnt vmcnt(3)
    v_cmpx_eq_u32 vcc, s36, v115
    s_waitcnt vmcnt(2)
    v_cmpx_eq_u32 vcc, s36, v119
    v_swap_b32 v113, v116
    s_waitcnt vmcnt(1)
    v_cmpx_eq_u32 vcc, s36, v123
    v_swap_b32 v114, v120
    v_swap_b32 v118, v121
    s_waitcnt vmcnt(0)
    v_cmpx_eq_u32 vcc, s36, v127
    v_mov_b32 v115, v124
    v_mov_b32 v119, v125
    v_mov_b32 v123, v126
    s_andn2_b64 s[48:49], s[46:47], vcc
    s_cbranch_scc1 L_retry
L_go:
    s_mov_b64 exec, -1
    v_mfma_f32_16x16x32_bf16 v[96:99], v[28:31], v[112:115], v[96:99]
    v_mfma_f32_16x16x32_bf16 v[100:103], v[28:31], v[116:119], v[100:103]
    v_mfma_f32_16x16x32_bf16 v[104:107], v[28:31], v[120:123], v[104:107]
    s_nop 5
    v_cvt_pk_bf16_f32 v20, v96, v97
    v_cvt_pk_bf16_f32 v21, v98, v99
    ds_write_b64 v4, v[20:21] offset:8192
    v_cvt_pk_bf16_f32 v22, v100, v101
    v_cvt_pk_bf16_f32 v23, v102, v103
    ds_write_b64 v6, v[22:23] offset:8200
    v_cvt_pk_bf16_f32 v24, v104, v105
    v_cvt_pk_bf16_f32 v25, v106, v107
    ds_write_b64 v6, v[24:25] offset:8208
L_b3:
    v_mov_b32 v11, 0
    v_mov_b32 v15, 0
    v_mov_b32 v19, 0
    s_waitcnt lgkmcnt(0)
    s_barrier
    ds_read_b32 v18, v55 offset:1304
    ds_read2_b32 v[8:9], v3 offset0:0 offset1:40
    ds_read2_b32 v[12:13], v3 offset0:16 offset1:56
    ds_read2_b32 v[16:17], v7 offset0:32 offset1:72
    ds_read_b32 v28, v66 offset:1280
    s_waitcnt lgkmcnt(4)
    v_cndmask_b32 v10, 0, v18, s[44:45]
    v_cndmask_b32 v14, 0, v18, s[52:53]
    v_cndmask_b32 v18, 0, v18, s[54:55]
    s_waitcnt lgkmcnt(3)
    v_mfma_f32_16x16x32_bf16 v[96:99], v[8:11], v[92:95], 0
    v_mfma_f32_16x16x32_bf16 v[100:103], v[8:11], v[108:111], 0
    s_waitcnt lgkmcnt(2)
    v_mfma_f32_16x16x32_bf16 v[112:115], v[12:15], v[92:95], 0
    s_waitcnt lgkmcnt(0)
    v_perm_b32 v28, v28, v28, s25
    v_xor_b32 v29, s43, v28
    v_mov_b64 v[30:31], v[28:29]
    v_mfma_f32_16x16x32_bf16 v[116:119], v[12:15], v[108:111], 0
    v_mul_f32 v104, v96, v68
    v_mul_f32 v105, v97, v69
    v_mul_f32 v106, v98, v70
    v_mul_f32 v107, v99, v71
    v_mfma_f32_16x16x32_bf16 v[120:123], v[16:19], v[92:95], 0
    v_fmac_f32 v104, v100, v80
    v_fmac_f32 v105, v101, v81
    v_fmac_f32 v106, v102, v82
    v_fmac_f32 v107, v103, v83
    v_mfma_f32_16x16x32_bf16 v[124:127], v[16:19], v[108:111], 0
    v_mul_f32 v100, v100, v68
    v_mul_f32 v101, v101, v69
    v_mul_f32 v102, v102, v70
    v_mul_f32 v103, v103, v71
    v_fma_f32 v100, -v96, v80, v100
    v_fma_f32 v101, -v97, v81, v101
    v_fma_f32 v102, -v98, v82, v102
    v_fma_f32 v103, -v99, v83, v103
    v_cvt_pk_bf16_f32 v20, v104, v100
    v_cvt_pk_bf16_f32 v21, v105, v101
    v_cvt_pk_bf16_f32 v22, v106, v102
    v_cvt_pk_bf16_f32 v23, v107, v103
    v_mul_f32 v104, v112, v72
    v_mul_f32 v105, v113, v73
    v_mfma_f32_16x16x32_bf16 v[8:11], v[20:23], v[32:35], v[28:31]
    v_mul_f32 v106, v114, v74
    v_mul_f32 v107, v115, v75
    v_mfma_f32_16x16x32_bf16 v[12:15], v[20:23], v[44:47], v[28:31]
    v_fmac_f32 v104, v116, v84
    v_fmac_f32 v105, v117, v85
    v_mfma_f32_16x16x32_bf16 v[16:19], v[20:23], v[56:59], v[28:31]
    v_fmac_f32 v106, v118, v86
    v_fmac_f32 v107, v119, v87
    v_mul_f32 v116, v116, v72
    v_mul_f32 v117, v117, v73
    v_mul_f32 v118, v118, v74
    v_mul_f32 v119, v119, v75
    v_fma_f32 v116, -v112, v84, v116
    v_fma_f32 v117, -v113, v85, v117
    v_fma_f32 v118, -v114, v86, v118
    v_fma_f32 v119, -v115, v87, v119
    v_cvt_pk_bf16_f32 v24, v104, v116
    v_cvt_pk_bf16_f32 v25, v105, v117
    v_cvt_pk_bf16_f32 v26, v106, v118
    v_cvt_pk_bf16_f32 v27, v107, v119
    v_mul_f32 v104, v120, v76
    v_mul_f32 v105, v121, v77
    v_mfma_f32_16x16x32_bf16 v[8:11], v[24:27], v[36:39], v[8:11]
    v_fmac_f32 v104, v124, v88
    v_fmac_f32 v105, v125, v89
    v_mfma_f32_16x16x32_bf16 v[12:15], v[24:27], v[48:51], v[12:15]
    v_mul_f32 v124, v124, v76
    v_mul_f32 v125, v125, v77
    v_mfma_f32_16x16x32_bf16 v[16:19], v[24:27], v[60:63], v[16:19]
    v_fma_f32 v124, -v120, v88, v124
    v_fma_f32 v125, -v121, v89, v125
    v_cvt_pk_bf16_f32 v4, v104, v124
    v_cvt_pk_bf16_f32 v5, v105, v125
    s_nop 1
    v_mfma_f32_16x16x16_bf16 v[8:11], v[4:5], v[40:41], v[8:11]
    v_mfma_f32_16x16x16_bf16 v[12:15], v[4:5], v[52:53], v[12:15]
    v_mfma_f32_16x16x16_bf16 v[16:19], v[4:5], v[64:65], v[16:19]
    s_nop 5
    ds_bpermute_b32 v104, v54, v8
    ds_bpermute_b32 v105, v54, v12
    ds_bpermute_b32 v106, v54, v16
    v_cvt_pk_bf16_f32 v96, v8, v9
    v_cvt_pk_bf16_f32 v97, v10, v11
    v_cvt_pk_bf16_f32 v98, v12, v13
    v_cvt_pk_bf16_f32 v99, v14, v15
    v_cvt_pk_bf16_f32 v100, v16, v17
    v_cvt_pk_bf16_f32 v101, v18, v19
    v_permlane16_swap_b32 v96, v98
    v_permlane16_swap_b32 v97, v99
    buffer_store_dwordx4 v[96:99], v1, s[8:11], s21 offen sc1
    s_mov_b64 exec, s[56:57]
    buffer_store_dwordx2 v[100:101], v2, s[8:11], s21 offen offset:1024 sc1
    s_mov_b64 exec, -1
    v_cvt_pk_bf16_f32 v115, v10, v9
    v_cvt_pk_bf16_f32 v113, v14, v13
    v_cvt_pk_bf16_f32 v117, v18, v17
    s_waitcnt lgkmcnt(0)
    v_cndmask_b32 v104, v104, v105, s[50:51]
    v_cndmask_b32 v105, v105, v106, s[50:51]
    v_permlane16_swap_b32 v115, v113
    v_cvt_pk_bf16_f32 v114, v104, v11
    v_cvt_pk_bf16_f32 v112, v105, v15
    v_cvt_pk_bf16_f32 v116, v106, v19
    s_nop 0
    v_permlane16_swap_b32 v114, v112
    buffer_store_dwordx4 v[112:115], v42, s[8:11], s22 offen sc1
    s_mov_b64 exec, s[56:57]
    buffer_store_dwordx2 v[116:117], v43, s[8:11], s22 offen sc1
L_fin:
L_end:
    s_endpgm
L_aux:
    s_and_b32 s24, s20, 3
    v_cvt_f32_u32 v33, v2
    v_and_b32 v125, 63, v0
    v_add_f32 v33, v33, v33
    s_lshl_b32 s22, s24, 4
    s_cmp_eq_u32 s24, 3
    s_cselect_b32 s22, 0, s22
    s_mov_b32 s23, 0x3ccccccd
    s_cselect_b32 s23, 0x3acccccd, s23
    v_add_u32 v32, s22, v22
    v_cvt_f32_u32 v32, v32
    v_mul_f32 v32, s23, v32
    v_mul_f32 v33, v33, v32
    v_add_f32 v34, v33, v33
    v_fmamk_f32 v33, v32, 0x42000000, v33
    v_fmamk_f32 v35, v32, 0x41800000, v34
    s_mul_i32 s22, s24, 3072
    v_lshl_add_u32 v36, v125, 4, s22
    v_cos_f32 v40, v34
    v_sin_f32 v52, v34
    v_add_f32 v34, v34, v32
    v_cos_f32 v44, v35
    v_sin_f32 v56, v35
    v_add_f32 v35, v35, v32
    v_cos_f32 v48, v33
    v_sin_f32 v60, v33
    v_add_f32 v33, v33, v32
    v_cos_f32 v41, v34
    v_sin_f32 v53, v34
    v_add_f32 v34, v34, v32
    v_cos_f32 v45, v35
    v_sin_f32 v57, v35
    v_add_f32 v35, v35, v32
    v_cos_f32 v49, v33
    v_sin_f32 v61, v33
    v_cos_f32 v42, v34
    v_sin_f32 v54, v34
    v_add_f32 v34, v34, v32
    v_cos_f32 v46, v35
    v_sin_f32 v58, v35
    v_add_f32 v35, v35, v32
    v_cos_f32 v43, v34
    v_sin_f32 v55, v34
    v_cos_f32 v47, v35
    v_sin_f32 v59, v35
    s_cbranch_scc1 L_craw
    v_cvt_pk_bf16_f32 v40, v40, v52
    v_cvt_pk_bf16_f32 v41, v41, v53
    v_cvt_pk_bf16_f32 v42, v42, v54
    v_cvt_pk_bf16_f32 v43, v43, v55
    v_cvt_pk_bf16_f32 v44, v44, v56
    v_cvt_pk_bf16_f32 v45, v45, v57
    v_cvt_pk_bf16_f32 v46, v46, v58
    v_cvt_pk_bf16_f32 v47, v47, v59
    v_cvt_pk_bf16_f32 v48, v48, v60
    v_cvt_pk_bf16_f32 v49, v49, v61
    s_branch L_cw
L_craw:
    ds_write_b128 v36, v[52:55] offset:17408
    ds_write_b128 v36, v[56:59] offset:18432
    ds_write_b128 v36, v[60:63] offset:19456
L_cw:
    ds_write_b128 v36, v[40:43] offset:14336
    ds_write_b128 v36, v[44:47] offset:15360
    ds_write_b128 v36, v[48:51] offset:16384
    s_lshl_b32 s22, s24, 8
    s_or_b32 s22, s22, s2
    s_cmp_gt_u32 s22, 1
    s_waitcnt lgkmcnt(0)
    s_cbranch_scc1 L_end
    s_mov_b32 s18, 2097280
    s_mov_b32 s19, 0x20000
    s_mov_b32 s21, 2097152
    s_brev_b32 s43, 1
    s_load_dword s36, s[16:17], s21
    s_load_dwordx2 s[8:9], s[0:1], 40
    v_and_b32 v1, 3, v0
    v_mov_b32 v5, 0
    s_movk_i32 s42, 1024
    s_waitcnt vmcnt(0) lgkmcnt(0)
    s_barrier
    s_cmp_eq_u32 s2, 0
    s_cbranch_scc1 L_rdc
    s_add_u32 s36, s36, 2654435769
    v_mov_b32 v8, s36
    s_mov_b64 exec, 1
    s_barrier
    buffer_store_dword v8, off, s[16:19], s21 sc1
    s_endpgm
L_codeend:
.section .rodata,"a"
.p2align 6
.amdhsa_kernel standalone__spectral_fnet__prompt_kernel
  .amdhsa_next_free_vgpr 128
  .amdhsa_next_free_sgpr 58
  .amdhsa_accum_offset 128
  .amdhsa_group_segment_fixed_size 0
  .amdhsa_kernarg_size 64
  .amdhsa_user_sgpr_count 2
  .amdhsa_user_sgpr_kernarg_segment_ptr 1
  .amdhsa_system_sgpr_workgroup_id_x 1
  .amdhsa_float_denorm_mode_32 3
.end_amdhsa_kernel
```
